```python
import torch

def _softmax(x, axis=-1):
    return torch.softmax(x, dim=axis)
def _gelu(x):
    return torch.nn.functional.gelu(x, approximate="tanh")
def _silu(x):
    return torch.nn.functional.silu(x)
def _sigmoid(x):
    return torch.sigmoid(x)
def _layernorm(x, axis=-1, eps=1e-5):
    m = x.mean(dim=axis, keepdim=True)
    v = x.var(dim=axis, keepdim=True, unbiased=False)
    return (x - m) / torch.sqrt(v + eps)
def _scatter_add(tgt, idx, src, axis=0):
    return tgt.clone().index_add_(axis, idx, src)
def _segment_sum(src, seg, n):
    out = torch.zeros((n,) + src.shape[1:], dtype=src.dtype)
    return out.index_add_(0, seg, src)
def _pad(x, pw):
    flat = tuple(v for pair in reversed(pw) for v in pair)
    return torch.nn.functional.pad(x, flat)

kernel_name = 'standalone__paged_block_table_kv_radixattention__decode'

def setup_inputs():

    _w = (lambda a: (lambda t: t.to(torch.bfloat16) if t.is_floating_point() else t)(torch.as_tensor(a)))
    B, H, Hkv, Dh = 2, 16, 8, 256
    Lk = 32768
    bs = 16
    nb = max(2, Lk // bs)
    P = max(1, nb // 2)
    n_phys = P + B * (nb - P)
    shared = torch.arange(P, dtype=torch.int64)
    priv = P + torch.arange(B * (nb - P), dtype=torch.int64).reshape(B, nb - P)
    bt = torch.cat([torch.tile(shared[None, :], (B, 1)), priv], dim=1)
    ctx = nb * bs - (torch.arange(1, B + 1, dtype=torch.int64) * 2654435761) % max(1, (nb * bs - P * bs) // 2)
    return {
        "q": _w((lambda *s: torch.randn(*s, dtype=torch.bfloat16) * 0.8)(B, H, Dh)),
        "k_cache": _w((lambda *s: torch.randn(*s, dtype=torch.bfloat16) * 0.8)(n_phys, bs, Hkv, Dh)),
        "v_cache": _w((lambda *s: torch.randn(*s, dtype=torch.bfloat16) * 0.05)(n_phys, bs, Hkv, Dh)),
        "block_table": _w(bt.to(torch.int64)),
        "ctx_lens": _w(torch.as_tensor(ctx).to(torch.int64)),
    }

def reference(q, k_cache, v_cache, block_table, ctx_lens):
    B, H, Dh = q.shape
    n_phys, bs, Hkv, _ = k_cache.shape
    nb = block_table.shape[1]
    Lk = nb * bs
    rep = H // Hkv
    k = k_cache[block_table].reshape(B, Lk, Hkv, Dh)
    v = v_cache[block_table].reshape(B, Lk, Hkv, Dh)
    k = (lambda x, n, axis: torch.repeat_interleave(x, n, dim=axis))(k, rep, axis=2)
    v = (lambda x, n, axis: torch.repeat_interleave(x, n, dim=axis))(v, rep, axis=2)
    scores = torch.einsum("bhd,bkhd->bhk", q, k) * (Dh ** -0.5)
    pos = torch.arange(Lk)
    valid = pos[None, :] < ctx_lens[:, None]
    scores = torch.where(valid[:, None, :], scores, -1e9)
    p = _softmax(scores, axis=-1)
    return torch.einsum("bhk,bkhd->bhd", p, v)
```

```asm
; @launch grid=(256,1,1) block=(256,1,1) lds=98304
.amdgcn_target "amdgcn-amd-amdhsa--gfx950"
.text
.globl standalone__paged_block_table_kv_radixattention__decode_kernel
.p2align 8
.type standalone__paged_block_table_kv_radixattention__decode_kernel,@function
standalone__paged_block_table_kv_radixattention__decode_kernel:
    s_load_dwordx16 s[4:19], s[0:1], 0
    s_getpc_b64 s[92:93]
L_pc:
    v_lshlrev_b32 v209, 7, v0
    v_cmp_gt_u32 vcc, ((L_end-L_pc)>>7)+1, v0
    s_nop 0
    s_and_saveexec_b64 s[94:95], vcc
    s_cbranch_execz L_nopf
    global_load_dword v208, v209, s[92:93]
L_nopf:
    s_mov_b64 exec, -1
    s_cmp_ge_u32 s2, 256
    s_cbranch_scc1 L_end
    v_lshrrev_b32 v184, 6, v0
    v_and_b32 v1, 63, v0
    s_lshr_b32 s37, s2, 3
    v_readfirstlane_b32 s36, v184
    s_and_b32 s37, s37, 7
    s_and_b32 s38, s2, 7
    s_lshr_b32 s3, s2, 6
    s_lshl_b32 s3, s3, 3
    s_add_u32 s38, s38, s3
    s_lshl_b32 s39, s37, 9
    v_lshrrev_b32 v184, 4, v1
    v_bfe_u32 v185, v1, 2, 2
    v_and_b32 v186, 3, v1
    v_lshlrev_b32 v187, 6, v184
    v_lshl_add_u32 v2, v185, 12, v187
    v_lshl_add_u32 v2, v186, 4, v2
    v_add_u32 v2, s39, v2
    v_and_b32 v188, 15, v1
    v_lshlrev_b32 v3, 12, v184
    v_lshl_add_u32 v3, v188, 4, v3
    v_add_u32 v3, s39, v3
    v_lshl_add_u32 v189, v185, 4, v187
    v_lshrrev_b32 v190, 1, v186
    v_lshl_add_u32 v189, v190, 13, v189
    v_and_b32 v190, 1, v1
    v_lshl_add_u32 v189, v190, 9, v189
    s_lshl_b32 s39, s39, 1
    v_add_u32 v189, s39, v189
    v_lshlrev_b32 v190, 5, v0
    v_add_u32 v191, 0x2000, v190
    s_lshl_b32 s3, s38, 4
    s_mov_b32 s22, 201326592
    s_mov_b32 s23, 0x20000
    s_mov_b32 s26, 201326592
    s_mov_b32 s27, 0x20000
    s_waitcnt lgkmcnt(0)
    s_load_dwordx2 s[40:41], s[12:13], 0
    s_add_u32 s44, s10, s3
    s_addc_u32 s45, s11, 0
    s_load_dwordx4 s[48:51], s[44:45], 0
    s_load_dword s53, s[18:19], 0
    global_load_dwordx4 v[192:195], v190, s[10:11]
    global_load_dwordx4 v[196:199], v190, s[10:11] offset:16
    global_load_dwordx4 v[200:203], v191, s[10:11]
    global_load_dwordx4 v[204:207], v191, s[10:11] offset:16
    global_load_dwordx4 v[4:7], v189, s[4:5]
    global_load_dwordx4 v[8:11], v189, s[4:5] offset:256
    s_mov_b32 s20, s6
    s_and_b32 s21, s7, 0xffff
    s_mov_b32 s24, s8
    s_and_b32 s25, s9, 0xffff
    s_lshl_b32 s3, s37, 2
    s_add_u32 s3, s3, s36
    s_lshl_b32 s3, s3, 5
    s_add_u32 s3, s3, s38
    s_lshl_b32 s39, s3, 10
    s_add_u32 s39, s39, 262144
    v_lshlrev_b32 v181, 4, v1
    v_add_u32 v181, s39, v181
    s_lshl_b32 s39, s3, 7
    s_add_u32 s39, s39, 65536
    v_lshlrev_b32 v182, 4, v1
    v_add_u32 v182, s39, v182
    s_cmp_lg_u32 s36, 0
    s_cbranch_scc1 L_noclear
    v_mov_b64 v[28:29], -1
    v_mov_b64 v[30:31], -1
    v_add_u32 v32, 32768, v181
    v_add_u32 v33, 65536, v181
    v_add_u32 v34, 98304, v181
    v_lshrrev_b32 v35, 3, v1
    v_mul_u32_u24 v35, 3968, v35
    v_add_u32 v35, v35, v182
    global_store_dwordx4 v181, v[28:31], s[18:19] sc1
    global_store_dwordx4 v32, v[28:31], s[18:19] sc1
    global_store_dwordx4 v33, v[28:31], s[18:19] sc1
    global_store_dwordx4 v34, v[28:31], s[18:19] sc1
    s_mov_b32 exec_hi, 0
    global_store_dwordx4 v35, v[28:31], s[18:19] sc1
    s_mov_b64 exec, -1
L_noclear:
    s_lshl_b32 s46, s36, 14
    s_getreg_b32 s3, hwreg(HW_REG_XCC_ID, 0, 3)
    s_lshl_b32 s3, s3, 9
    s_add_u32 s3, s3, 36864
    v_lshlrev_b32 v212, 3, v1
    v_add_u32 v212, s3, v212
    s_getreg_b32 s39, hwreg(HW_REG_HW_ID, 13, 2)
    s_lshl_b32 s39, s39, 7
    s_add_u32 s3, s3, s39
    s_getreg_b32 s39, hwreg(HW_REG_HW_ID, 8, 4)
    s_lshl_b32 s39, s39, 3
    s_add_u32 s3, s3, s39
    s_lshl_b32 s39, s36, 1
    s_add_u32 s3, s3, s39
    v_mov_b32 v210, s3
    v_mov_b32 v211, 0x5a00
    s_waitcnt lgkmcnt(0)
    s_lshl_b32 s48, s48, 16
    s_add_u32 s48, s48, s46
    s_lshl_b32 s49, s49, 16
    s_add_u32 s49, s49, s46
    s_lshl_b32 s50, s50, 16
    s_add_u32 s50, s50, s46
    s_lshl_b32 s51, s51, 16
    s_add_u32 s51, s51, s46
    s_cmp_le_i32 s40, 0
    s_cselect_b32 s85, 0x8000, s40
    s_cmp_gt_u32 s85, 2047
    s_cselect_b32 s47, 1, 0
    s_cbranch_scc0 L_noearly
    buffer_load_dwordx4 v[52:55], v2, s[20:23], s48 offen offset:0 nt
    buffer_load_dwordx4 v[56:59], v2, s[20:23], s48 offen offset:256 nt
    buffer_load_dwordx4 v[60:63], v2, s[20:23], s49 offen offset:0 nt
    buffer_load_dwordx4 v[64:67], v2, s[20:23], s49 offen offset:256 nt
    buffer_load_dwordx4 v[68:71], v2, s[20:23], s50 offen offset:0 nt
    buffer_load_dwordx4 v[72:75], v2, s[20:23], s50 offen offset:256 nt
    buffer_load_dwordx4 v[76:79], v2, s[20:23], s51 offen offset:0 nt
    buffer_load_dwordx4 v[80:83], v2, s[20:23], s51 offen offset:256 nt
    v_add_u32 v211, 1, v211
    s_mov_b64 exec, 1
    global_store_short v210, v211, s[18:19]
    s_mov_b64 exec, -1
    s_branch L_early_done
L_noearly:
    v_mov_b64 v[84:85], 0
    v_mov_b64 v[86:87], 0
    v_mov_b64 v[88:89], 0
    v_mov_b64 v[90:91], 0
    v_mov_b64 v[92:93], 0
    v_mov_b64 v[94:95], 0
    v_mov_b64 v[96:97], 0
    v_mov_b64 v[98:99], 0
    v_mov_b64 v[100:101], 0
    v_mov_b64 v[102:103], 0
    v_mov_b64 v[104:105], 0
    v_mov_b64 v[106:107], 0
    v_mov_b64 v[108:109], 0
    v_mov_b64 v[110:111], 0
    v_mov_b64 v[112:113], 0
    v_mov_b64 v[114:115], 0
    s_waitcnt vmcnt(0)
L_early_done:
    s_add_u32 s52, s53, 1
    s_max_u32 s52, s52, 1
    s_mov_b32 s54, s52
    s_mov_b32 s53, 0
    s_lshl_b32 s3, s2, 2
    s_add_u32 s3, s3, s36
    s_cmp_lg_u32 s3, 0
    s_cbranch_scc1 L_nocas
    s_atomic_cmpswap s[52:53], s[16:17], 0x0
L_nocas:
    s_mov_b32 s64, 0x33333333
    s_mov_b32 s65, 0x33333333
    s_mov_b32 s66, 0xcccccccc
    s_mov_b32 s67, 0xcccccccc
    s_cmp_le_i32 s40, 0
    s_cselect_b64 s[64:65], 0, s[64:65]
    s_cmp_le_i32 s41, 0
    s_cselect_b32 s86, 0x8000, s41
    s_cselect_b64 s[66:67], 0, s[66:67]
    s_or_b64 s[64:65], s[64:65], s[66:67]
    s_min_u32 s85, s85, 0x8000
    s_min_u32 s86, s86, 0x8000
    s_add_u32 s83, s85, 15
    s_lshr_b32 s83, s83, 4
    s_add_u32 s84, s86, 15
    s_lshr_b32 s84, s84, 4
    v_mov_b64 v[116:117], 0
    v_mov_b64 v[118:119], 0
    v_mov_b64 v[120:121], 0
    v_mov_b64 v[122:123], 0
    v_mov_b64 v[124:125], 0
    v_mov_b64 v[126:127], 0
    v_mov_b64 v[128:129], 0
    v_mov_b64 v[130:131], 0
    v_mov_b64 v[132:133], 0
    v_mov_b64 v[134:135], 0
    v_mov_b64 v[136:137], 0
    v_mov_b64 v[138:139], 0
    v_mov_b64 v[140:141], 0
    v_mov_b64 v[142:143], 0
    v_mov_b64 v[144:145], 0
    v_mov_b64 v[146:147], 0
    v_mov_b64 v[148:149], 0
    v_mov_b64 v[150:151], 0
    v_mov_b64 v[152:153], 0
    v_mov_b64 v[154:155], 0
    v_mov_b64 v[156:157], 0
    v_mov_b64 v[158:159], 0
    v_mov_b64 v[160:161], 0
    v_mov_b64 v[162:163], 0
    v_mov_b64 v[164:165], 0
    v_mov_b64 v[166:167], 0
    v_mov_b64 v[168:169], 0
    v_mov_b64 v[170:171], 0
    v_mov_b64 v[172:173], 0
    v_mov_b64 v[174:175], 0
    v_mov_b64 v[176:177], 0
    v_mov_b64 v[178:179], 0
    v_mov_b64 v[26:27], 0
    v_mov_b64 v[22:23], 0
    v_mov_b64 v[24:25], 0
    v_and_b32 v183, 31, v1
    s_lshl_b32 s3, s37, 5
    v_add_u32 v183, s3, v183
    v_lshlrev_b32 v183, 7, v183
    v_mov_b32 v20, 0
    v_mov_b32 v18, 0xf149f2ca
    v_mov_b32 v180, 0xff800000
    s_mov_b32 s80, 1035512379
    v_mul_f32 v19, s80, v18
    s_mov_b32 s74, 0xf0f0f0f0
    s_mov_b32 s75, 0xf0f0f0f0
    s_mov_b32 s76, 0xff00ff00
    s_mov_b32 s77, 0xff00ff00
    s_mov_b32 s78, 0x05040100
    s_mov_b32 s79, 0x07060302
    s_getreg_b32 s3, hwreg(HW_REG_XCC_ID)
    s_and_b32 s3, s3, 7
    s_mov_b32 s43, -11324621
    s_cmp_eq_u32 s3, 1
    s_cselect_b32 s43, -13212058, s43
    s_cmp_eq_u32 s3, 2
    s_cselect_b32 s43, -11534336, s43
    s_cmp_eq_u32 s3, 3
    s_cselect_b32 s43, -13212058, s43
    s_cmp_eq_u32 s3, 4
    s_cselect_b32 s43, -10695475, s43
    s_cmp_eq_u32 s3, 5
    s_cselect_b32 s43, -13002342, s43
    s_cmp_eq_u32 s3, 6
    s_cselect_b32 s43, -10380902, s43
    s_cmp_eq_u32 s3, 7
    s_cselect_b32 s43, -12687770, s43
    s_getreg_b32 s3, hwreg(HW_REG_HW_ID, 8, 4)
    s_mul_i32 s3, s3, 167772
    s_add_u32 s43, s43, s3
    s_bitcmp0_b32 s37, 0
    s_cselect_b32 s3, 943718, 0
    s_add_u32 s43, s43, s3
    s_cmp_ge_u32 s38, 24
    s_cselect_b32 s3, 838861, 0
    s_add_u32 s43, s43, s3
    s_cmp_eq_u32 s36, 0
    s_cselect_b32 s3, 314573, 0
    s_add_u32 s43, s43, s3
    s_max_i32 s55, s43, 0
    s_lshl_b32 s55, s55, 8
    s_sub_u32 s3, 0, s43
    s_max_i32 s70, s3, 0
    s_lshl_b32 s70, s70, 8
    s_mov_b32 s42, 0
    s_cmp_lg_u32 s36, 0
    s_cbranch_scc1 L_w1
    s_waitcnt vmcnt(14)
    s_branch L_w2
L_w1:
    s_waitcnt vmcnt(9)
L_w2:
    ds_write_b128 v190, v[192:195]
    ds_write_b128 v190, v[196:199] offset:16
    ds_write_b128 v191, v[200:203]
    ds_write_b128 v191, v[204:207] offset:16
    v_cmp_eq_u32 s[56:57], v192, v200
    v_cmp_eq_u32 s[58:59], v193, v201
    v_cmp_eq_u32 s[60:61], v194, v202
    v_cmp_eq_u32 s[62:63], v195, v203
    v_cmp_eq_u32 s[92:93], v196, v204
    v_cmp_eq_u32 s[94:95], v197, v205
    v_cmp_eq_u32 s[96:97], v198, v206
    v_cmp_eq_u32 s[98:99], v199, v207
    s_and_b64 s[58:59], s[58:59], s[56:57]
    s_and_b64 s[60:61], s[60:61], s[58:59]
    s_and_b64 s[62:63], s[62:63], s[60:61]
    s_and_b64 s[92:93], s[92:93], s[62:63]
    s_and_b64 s[94:95], s[94:95], s[92:93]
    s_and_b64 s[96:97], s[96:97], s[94:95]
    s_and_b64 s[98:99], s[98:99], s[96:97]
    s_ff0_i32_b64 s3, s[98:99]
    s_lshl_b32 s39, s36, 6
    s_add_u32 s39, s39, s3
    s_lshl_b32 s39, s39, 3
    s_bitcmp1_b64 s[56:57], s3
    s_addc_u32 s39, s39, 0
    s_bitcmp1_b64 s[58:59], s3
    s_addc_u32 s39, s39, 0
    s_bitcmp1_b64 s[60:61], s3
    s_addc_u32 s39, s39, 0
    s_bitcmp1_b64 s[62:63], s3
    s_addc_u32 s39, s39, 0
    s_bitcmp1_b64 s[92:93], s3
    s_addc_u32 s39, s39, 0
    s_bitcmp1_b64 s[94:95], s3
    s_addc_u32 s39, s39, 0
    s_bitcmp1_b64 s[96:97], s3
    s_addc_u32 s39, s39, 0
    s_cmp_lt_i32 s3, 0
    s_cselect_b32 s39, 2048, s39
    s_lshl_b32 s3, s36, 2
    v_mov_b32 v184, s3
    v_mov_b32 v185, s39
    ds_write_b32 v184, v185 offset:16384
    v_cndmask_b32 v4, 0, v4, s[64:65]
    v_cndmask_b32 v5, 0, v5, s[64:65]
    v_cndmask_b32 v6, 0, v6, s[64:65]
    v_cndmask_b32 v7, 0, v7, s[64:65]
    v_cndmask_b32 v8, 0, v8, s[64:65]
    v_cndmask_b32 v9, 0, v9, s[64:65]
    v_cndmask_b32 v10, 0, v10, s[64:65]
    v_cndmask_b32 v11, 0, v11, s[64:65]
    v_mov_b32 v184, 0
    s_cmp_eq_u32 s36, 0
    s_cselect_b32 s87, 4, 0
    s_waitcnt lgkmcnt(0)
    s_barrier
    ds_read_b128 v[192:195], v184 offset:16384
    s_waitcnt lgkmcnt(0)
    v_min_u32 v192, v192, v193
    v_min3_u32 v192, v192, v194, v195
    s_min_u32 s3, s83, s84
    v_readfirstlane_b32 s82, v192
    s_nop 0
    s_min_u32 s82, s82, s3
    s_add_u32 s81, s83, s84
    s_sub_u32 s81, s81, s82
    s_sub_u32 s39, s82, s83
    s_lshl_b32 s66, s36, 2
    s_sub_u32 s64, s85, s66
    s_sub_u32 s65, s86, s66
    v_add_u32 v196, 0, v1
    s_lshr_b32 s3, s81, 7
    s_lshl_b32 s3, s3, 2
    v_cmp_gt_u32 vcc, s3, v196
    v_lshlrev_b32 v192, 5, v196
    v_and_b32 v197, 0xffffff80, v192
    v_add_u32 v192, s38, v192
    v_and_b32 v196, 3, v196
    s_lshl_b32 s3, s38, 2
    v_add3_u32 v197, v197, s3, v196
    v_cndmask_b32 v192, v192, v197, vcc
    v_cmp_gt_u32 s[56:57], s83, v192
    v_add_u32 v193, s39, v192
    v_cmp_gt_u32 s[58:59], s81, v192
    v_cndmask_b32 v193, v193, v192, s[56:57]
    v_min_u32 v194, 2047, v193
    v_lshlrev_b32 v194, 2, v194
    v_add_u32 v196, 0x2000, v194
    v_cndmask_b32 v194, v196, v194, s[56:57]
    ds_read_b32 v195, v194
    v_add_u32 v204, 64, v1
    s_lshr_b32 s3, s81, 7
    s_lshl_b32 s3, s3, 2
    v_cmp_gt_u32 vcc, s3, v204
    v_lshlrev_b32 v200, 5, v204
    v_and_b32 v205, 0xffffff80, v200
    v_add_u32 v200, s38, v200
    v_and_b32 v204, 3, v204
    s_lshl_b32 s3, s38, 2
    v_add3_u32 v205, v205, s3, v204
    v_cndmask_b32 v200, v200, v205, vcc
    v_cmp_gt_u32 s[60:61], s83, v200
    v_add_u32 v201, s39, v200
    v_cmp_gt_u32 s[62:63], s81, v200
    v_cndmask_b32 v201, v201, v200, s[60:61]
    v_min_u32 v202, 2047, v201
    v_lshlrev_b32 v202, 2, v202
    v_add_u32 v204, 0x2000, v202
    v_cndmask_b32 v202, v204, v202, s[60:61]
    ds_read_b32 v203, v202
    v_mov_b32 v188, 0x3333
    v_mov_b32 v189, 0x33333333
    v_mov_b32 v190, 0xcccc
    v_mov_b32 v191, 0xcccccccc
    v_lshlrev_b32 v196, 4, v193
    v_sub_u32 v197, s64, v196
    v_sub_u32 v198, s65, v196
    v_cmp_gt_u32 vcc, s82, v192
    s_andn2_b64 s[92:93], s[58:59], s[56:57]
    s_or_b64 s[92:93], s[92:93], vcc
    v_cndmask_b32 v197, 0, v197, s[56:57]
    v_cndmask_b32 v198, 0, v198, s[92:93]
    v_cmp_lt_i32 s[94:95], 0, v197
    v_cmp_lt_i32 s[96:97], 1, v197
    v_cmp_lt_i32 s[98:99], 2, v197
    v_cmp_lt_i32 vcc, 3, v197
    v_cndmask_b32 v13, 0, v188, s[94:95]
    v_cndmask_b32 v13, v13, v189, s[96:97]
    v_cndmask_b32 v14, 0, v188, s[98:99]
    v_cndmask_b32 v14, v14, v189, vcc
    v_cmp_lt_i32 s[94:95], 0, v198
    v_cmp_lt_i32 s[96:97], 1, v198
    v_cmp_lt_i32 s[98:99], 2, v198
    v_cmp_lt_i32 vcc, 3, v198
    v_cndmask_b32 v186, 0, v190, s[94:95]
    v_cndmask_b32 v186, v186, v191, s[96:97]
    v_cndmask_b32 v187, 0, v190, s[98:99]
    v_cndmask_b32 v187, v187, v191, vcc
    v_or_b32 v13, v13, v186
    v_or_b32 v14, v14, v187
    s_waitcnt lgkmcnt(1)
    v_lshlrev_b32 v195, 16, v195
    v_cmp_ne_u32 vcc, 0, v13
    v_add_u32 v195, s46, v195
    v_mov_b32 v184, 4026531840
    v_cndmask_b32 v12, v184, v195, vcc
    v_lshlrev_b32 v204, 4, v201
    v_sub_u32 v205, s64, v204
    v_sub_u32 v206, s65, v204
    v_cmp_gt_u32 vcc, s82, v200
    s_andn2_b64 s[92:93], s[62:63], s[60:61]
    s_or_b64 s[92:93], s[92:93], vcc
    v_cndmask_b32 v205, 0, v205, s[60:61]
    v_cndmask_b32 v206, 0, v206, s[92:93]
    v_cmp_lt_i32 s[94:95], 0, v205
    v_cmp_lt_i32 s[96:97], 1, v205
    v_cmp_lt_i32 s[98:99], 2, v205
    v_cmp_lt_i32 vcc, 3, v205
    v_cndmask_b32 v16, 0, v188, s[94:95]
    v_cndmask_b32 v16, v16, v189, s[96:97]
    v_cndmask_b32 v17, 0, v188, s[98:99]
    v_cndmask_b32 v17, v17, v189, vcc
    v_cmp_lt_i32 s[94:95], 0, v206
    v_cmp_lt_i32 s[96:97], 1, v206
    v_cmp_lt_i32 s[98:99], 2, v206
    v_cmp_lt_i32 vcc, 3, v206
    v_cndmask_b32 v186, 0, v190, s[94:95]
    v_cndmask_b32 v186, v186, v191, s[96:97]
    v_cndmask_b32 v187, 0, v190, s[98:99]
    v_cndmask_b32 v187, v187, v191, vcc
    v_or_b32 v16, v16, v186
    v_or_b32 v17, v17, v187
    s_waitcnt lgkmcnt(0)
    v_lshlrev_b32 v203, 16, v203
    v_cmp_ne_u32 vcc, 0, v16
    v_add_u32 v203, s46, v203
    v_mov_b32 v184, 4026531840
    v_cndmask_b32 v15, v184, v203, vcc
    s_sub_u32 s3, s81, s38
    s_add_u32 s3, s3, 31
    s_ashr_i32 s3, s3, 5
    s_max_i32 s3, s3, 1
    s_lshl_b32 s39, s3, 5
    s_sub_u32 s39, s39, s81
    s_mul_i32 s39, s39, 31457
    s_add_u32 s43, s43, s39
    s_add_u32 s3, s3, 3
    s_lshr_b32 s73, s3, 2
    s_mov_b32 s72, 0
    s_lshl_b32 s69, s36, 30
    s_mov_b32 s68, s69
    v_readlane_b32 s48, v12, s72
    s_add_u32 s3, s72, 1
    v_readlane_b32 s49, v12, s3
    s_add_u32 s3, s72, 2
    v_readlane_b32 s50, v12, s3
    s_add_u32 s3, s72, 3
    v_readlane_b32 s51, v12, s3
    s_cmp_eq_u32 s47, 1
    s_nop 3
    s_cbranch_scc0 L_burst
    buffer_load_dwordx4 v[84:87], v3, s[24:27], s48 offen offset:0 nt
    buffer_load_dwordx4 v[88:91], v3, s[24:27], s49 offen offset:0 nt
    buffer_load_dwordx4 v[92:95], v3, s[24:27], s50 offen offset:0 nt
    buffer_load_dwordx4 v[96:99], v3, s[24:27], s51 offen offset:0 nt
    buffer_load_dwordx4 v[100:103], v3, s[24:27], s48 offen offset:256 nt
    buffer_load_dwordx4 v[104:107], v3, s[24:27], s49 offen offset:256 nt
    buffer_load_dwordx4 v[108:111], v3, s[24:27], s50 offen offset:256 nt
    global_load_dwordx2 v[214:215], v212, s[18:19] nt
    buffer_load_dwordx4 v[112:115], v3, s[24:27], s51 offen offset:256 nt
    v_add_u32 v211, 1, v211
    s_mov_b64 exec, 1
    global_store_short v210, v211, s[18:19]
    s_mov_b64 exec, -1
    v_readlane_b32 s56, v13, s72
    v_readlane_b32 s57, v14, s72
    s_add_u32 s72, s72, 1
    v_readlane_b32 s58, v13, s72
    v_readlane_b32 s59, v14, s72
    s_add_u32 s72, s72, 1
    v_readlane_b32 s60, v13, s72
    v_readlane_b32 s61, v14, s72
    s_add_u32 s72, s72, 1
    v_readlane_b32 s62, v13, s72
    v_readlane_b32 s63, v14, s72
    s_add_u32 s72, s72, 1
    s_branch L_burst_qk
.p2align 6
L_loop:
    s_add_u32 s69, s69, s55
    s_cbranch_scc1 L_lax0
    s_add_u32 s68, s68, s70
    s_cbranch_scc0 L_nrm0
    s_waitcnt vmcnt(6)
L_nrm0:
    s_waitcnt vmcnt(7)
L_lax0:
    s_waitcnt vmcnt(8)
    buffer_load_dwordx4 v[52:55], v2, s[20:23], s48 offen offset:0 nt
    v_pk_mul_f32 v[116:117], v[116:117], v[22:23]
    v_pk_mul_f32 v[118:119], v[118:119], v[24:25]
    v_pk_mul_f32 v[120:121], v[120:121], v[22:23]
    v_pk_mul_f32 v[122:123], v[122:123], v[24:25]
    v_pk_mul_f32 v[124:125], v[124:125], v[22:23]
    v_pk_mul_f32 v[126:127], v[126:127], v[24:25]
    v_pk_mul_f32 v[128:129], v[128:129], v[22:23]
    v_pk_mul_f32 v[130:131], v[130:131], v[24:25]
    v_pk_mul_f32 v[132:133], v[132:133], v[22:23]
    v_pk_mul_f32 v[134:135], v[134:135], v[24:25]
    v_pk_mul_f32 v[136:137], v[136:137], v[22:23]
    v_pk_mul_f32 v[138:139], v[138:139], v[24:25]
    v_pk_mul_f32 v[140:141], v[140:141], v[22:23]
    v_pk_mul_f32 v[142:143], v[142:143], v[24:25]
    v_pk_mul_f32 v[144:145], v[144:145], v[22:23]
    v_pk_mul_f32 v[146:147], v[146:147], v[24:25]
    s_add_u32 s69, s69, s55
    s_cbranch_scc1 L_lax1
    s_add_u32 s68, s68, s70
    s_cbranch_scc0 L_nrm1
    s_waitcnt vmcnt(6)
L_nrm1:
    s_waitcnt vmcnt(7)
L_lax1:
    s_waitcnt vmcnt(8)
    buffer_load_dwordx4 v[56:59], v2, s[20:23], s48 offen offset:256 nt
    v_readlane_b32 s56, v13, s72
    v_readlane_b32 s57, v14, s72
    s_add_u32 s72, s72, 1
    v_readlane_b32 s58, v13, s72
    v_readlane_b32 s59, v14, s72
    s_add_u32 s72, s72, 1
    v_readlane_b32 s60, v13, s72
    v_readlane_b32 s61, v14, s72
    s_add_u32 s72, s72, 1
    v_readlane_b32 s62, v13, s72
    v_readlane_b32 s63, v14, s72
    s_add_u32 s72, s72, 1
    s_add_u32 s69, s69, s55
    s_cbranch_scc1 L_lax2
    s_add_u32 s68, s68, s70
    s_cbranch_scc0 L_nrm2
    s_waitcnt vmcnt(6)
L_nrm2:
    s_waitcnt vmcnt(7)
L_lax2:
    s_waitcnt vmcnt(8)
    buffer_load_dwordx4 v[60:63], v2, s[20:23], s49 offen offset:0 nt
    v_perm_b32 v44, v88, v84, s78
    v_perm_b32 v45, v96, v92, s78
    v_perm_b32 v46, v88, v84, s79
    v_perm_b32 v47, v96, v92, s79
    v_mfma_f32_4x4x4_16b_bf16 v[116:119], v[26:27], v[44:45], v[116:119]
    v_perm_b32 v48, v89, v85, s78
    v_perm_b32 v49, v97, v93, s78
    v_mfma_f32_4x4x4_16b_bf16 v[120:123], v[26:27], v[46:47], v[120:123]
    v_perm_b32 v50, v89, v85, s79
    v_perm_b32 v51, v97, v93, s79
    v_mfma_f32_4x4x4_16b_bf16 v[124:127], v[26:27], v[48:49], v[124:127]
    s_nop 0
    v_mfma_f32_4x4x4_16b_bf16 v[128:131], v[26:27], v[50:51], v[128:131]
    s_add_u32 s69, s69, s55
    s_cbranch_scc1 L_lax3
    s_add_u32 s68, s68, s70
    s_cbranch_scc0 L_nrm3
    s_waitcnt vmcnt(6)
L_nrm3:
    s_waitcnt vmcnt(7)
L_lax3:
    s_waitcnt vmcnt(8)
    buffer_load_dwordx4 v[64:67], v2, s[20:23], s49 offen offset:256 nt
    v_perm_b32 v44, v90, v86, s78
    v_perm_b32 v45, v98, v94, s78
    v_perm_b32 v46, v90, v86, s79
    v_perm_b32 v47, v98, v94, s79
    v_mfma_f32_4x4x4_16b_bf16 v[132:135], v[26:27], v[44:45], v[132:135]
    v_perm_b32 v48, v91, v87, s78
    v_perm_b32 v49, v99, v95, s78
    v_mfma_f32_4x4x4_16b_bf16 v[136:139], v[26:27], v[46:47], v[136:139]
    v_perm_b32 v50, v91, v87, s79
    v_perm_b32 v51, v99, v95, s79
    v_mfma_f32_4x4x4_16b_bf16 v[140:143], v[26:27], v[48:49], v[140:143]
    s_nop 0
    v_mfma_f32_4x4x4_16b_bf16 v[144:147], v[26:27], v[50:51], v[144:147]
    s_add_u32 s69, s69, s55
    s_cbranch_scc1 L_lax4
    s_add_u32 s68, s68, s70
    s_cbranch_scc0 L_nrm4
    s_waitcnt vmcnt(5)
L_nrm4:
    s_waitcnt vmcnt(7)
L_lax4:
    s_waitcnt vmcnt(8)
    buffer_load_dwordx4 v[68:71], v2, s[20:23], s50 offen offset:0 nt
    v_pk_mul_f32 v[148:149], v[148:149], v[22:23]
    v_pk_mul_f32 v[150:151], v[150:151], v[24:25]
    v_pk_mul_f32 v[152:153], v[152:153], v[22:23]
    v_pk_mul_f32 v[154:155], v[154:155], v[24:25]
    v_pk_mul_f32 v[156:157], v[156:157], v[22:23]
    v_pk_mul_f32 v[158:159], v[158:159], v[24:25]
    v_pk_mul_f32 v[160:161], v[160:161], v[22:23]
    v_pk_mul_f32 v[162:163], v[162:163], v[24:25]
    v_pk_mul_f32 v[164:165], v[164:165], v[22:23]
    v_pk_mul_f32 v[166:167], v[166:167], v[24:25]
    v_pk_mul_f32 v[168:169], v[168:169], v[22:23]
    v_pk_mul_f32 v[170:171], v[170:171], v[24:25]
    v_pk_mul_f32 v[172:173], v[172:173], v[22:23]
    v_pk_mul_f32 v[174:175], v[174:175], v[24:25]
    v_pk_mul_f32 v[176:177], v[176:177], v[22:23]
    v_pk_mul_f32 v[178:179], v[178:179], v[24:25]
    s_add_u32 s69, s69, s55
    s_cbranch_scc1 L_lax5
    s_add_u32 s68, s68, s70
    s_cbranch_scc0 L_nrm5
    s_waitcnt vmcnt(4)
L_nrm5:
    s_waitcnt vmcnt(6)
L_lax5:
    s_waitcnt vmcnt(8)
    buffer_load_dwordx4 v[72:75], v2, s[20:23], s50 offen offset:256 nt
    s_cmp_eq_u32 s42, 0
    s_mov_b32 s42, 1
    s_cbranch_scc1 L_nofb0
    v_readfirstlane_b32 s3, v211
    s_mov_b32 s44, 0x00100010
    s_sub_u32 s3, 9, s3
    s_pack_ll_b32_b16 s3, s3, s3
    s_mov_b32 s45, 0x00040004
    v_pk_add_u16 v214, v214, s3
    v_pk_add_u16 v215, v215, s3
    s_mov_b32 s47, 0xfff8fff8
    v_pk_min_u16 v214, v214, s44
    v_pk_min_u16 v215, v215, s44
    v_pk_lshrrev_b16 v184, s45, v214
    v_pk_lshrrev_b16 v185, s45, v215
    v_pk_mad_u16 v214, v184, s47, v214
    v_pk_mad_u16 v215, v185, s47, v215
    v_pk_add_u16 v214, v214, v215
    s_mov_b32 s3, -2089
    v_lshrrev_b32 v215, 16, v214
    v_and_b32 v214, 0xffff, v214
    v_add_u32 v214, v214, v215
    s_nop 1
    v_add_u32_dpp v214, v214, v214 row_ror:1 row_mask:0xf bank_mask:0xf
    s_nop 1
    v_add_u32_dpp v214, v214, v214 row_ror:2 row_mask:0xf bank_mask:0xf
    s_nop 1
    v_add_u32_dpp v214, v214, v214 row_ror:4 row_mask:0xf bank_mask:0xf
    s_nop 1
    v_add_u32_dpp v214, v214, v214 row_ror:8 row_mask:0xf bank_mask:0xf
    s_nop 0
    v_readlane_b32 s39, v214, 0
    v_readlane_b32 s44, v214, 16
    v_readlane_b32 s45, v214, 32
    v_readlane_b32 s47, v214, 48
    s_add_u32 s3, s3, s39
    s_add_u32 s44, s44, s45
    s_add_u32 s3, s3, s47
    s_add_u32 s3, s3, s44
    s_max_i32 s3, s3, -1024
    s_min_i32 s3, s3, 1024
    s_mul_i32 s3, s3, 78643
    s_add_u32 s3, s3, s43
    s_min_i32 s3, s3, 12582912
    s_max_i32 s3, s3, -16609443
    s_max_i32 s55, s3, 0
    s_sub_u32 s3, 0, s3
    s_max_i32 s70, s3, 0
    s_lshl_b32 s55, s55, 8
    s_lshl_b32 s70, s70, 8
L_nofb0:
    s_add_u32 s69, s69, s55
    s_cbranch_scc1 L_lax6
    s_add_u32 s68, s68, s70
    s_cbranch_scc0 L_nrm6
    s_waitcnt vmcnt(4)
L_nrm6:
    s_waitcnt vmcnt(5)
L_lax6:
    s_waitcnt vmcnt(7)
    buffer_load_dwordx4 v[76:79], v2, s[20:23], s51 offen offset:0 nt
    v_perm_b32 v44, v104, v100, s78
    v_perm_b32 v45, v112, v108, s78
    v_perm_b32 v46, v104, v100, s79
    v_perm_b32 v47, v112, v108, s79
    v_mfma_f32_4x4x4_16b_bf16 v[148:151], v[26:27], v[44:45], v[148:151]
    v_perm_b32 v48, v105, v101, s78
    v_perm_b32 v49, v113, v109, s78
    v_mfma_f32_4x4x4_16b_bf16 v[152:155], v[26:27], v[46:47], v[152:155]
    v_perm_b32 v50, v105, v101, s79
    v_perm_b32 v51, v113, v109, s79
    v_mfma_f32_4x4x4_16b_bf16 v[156:159], v[26:27], v[48:49], v[156:159]
    s_nop 0
    v_mfma_f32_4x4x4_16b_bf16 v[160:163], v[26:27], v[50:51], v[160:163]
    s_add_u32 s69, s69, s55
    s_cbranch_scc1 L_lax7
    s_add_u32 s68, s68, s70
    s_cbranch_scc0 L_nrm7
    s_waitcnt vmcnt(4)
L_nrm7:
    s_waitcnt vmcnt(5)
L_lax7:
    s_waitcnt vmcnt(6)
    buffer_load_dwordx4 v[80:83], v2, s[20:23], s51 offen offset:256 nt
    v_add_u32 v211, 1, v211
    s_mov_b64 exec, 1
    global_store_short v210, v211, s[18:19]
    s_mov_b64 exec, -1
    v_perm_b32 v44, v106, v102, s78
    v_perm_b32 v45, v114, v110, s78
    v_perm_b32 v46, v106, v102, s79
    v_perm_b32 v47, v114, v110, s79
    v_mfma_f32_4x4x4_16b_bf16 v[164:167], v[26:27], v[44:45], v[164:167]
    v_perm_b32 v48, v107, v103, s78
    v_perm_b32 v49, v115, v111, s78
    v_mfma_f32_4x4x4_16b_bf16 v[168:171], v[26:27], v[46:47], v[168:171]
    v_perm_b32 v50, v107, v103, s79
    v_perm_b32 v51, v115, v111, s79
    v_mfma_f32_4x4x4_16b_bf16 v[172:175], v[26:27], v[48:49], v[172:175]
    s_nop 0
    v_mfma_f32_4x4x4_16b_bf16 v[176:179], v[26:27], v[50:51], v[176:179]
    s_add_u32 s69, s69, s55
    s_cbranch_scc1 L_lax8
    s_add_u32 s68, s68, s70
    s_cbranch_scc0 L_nrm8
    s_waitcnt vmcnt(5)
L_nrm8:
    s_waitcnt vmcnt(6)
L_lax8:
    s_waitcnt vmcnt(7)
    buffer_load_dwordx4 v[84:87], v3, s[24:27], s48 offen offset:0 nt
    v_mfma_f32_16x16x32_bf16 v[28:31], v[52:55], v[4:7], 0
    v_mfma_f32_16x16x32_bf16 v[28:31], v[56:59], v[8:11], v[28:31]
    s_cmp_eq_u32 s87, 0
    s_cbranch_scc1 L_st_done
    s_cmp_eq_u32 s87, 5
    s_cbranch_scc1 L_st_clr
    s_cmp_eq_u32 s87, 4
    s_cbranch_scc1 L_st_load
    s_cmp_eq_u32 s87, 3
    s_cbranch_scc1 L_st_tag
    s_cmp_eq_u32 s87, 2
    s_cbranch_scc1 L_st_fl
    v_cmp_ne_u32 vcc, s71, v209
    s_nop 0
    s_cmp_eq_u64 vcc, 0
    s_cselect_b32 s87, 0, 2
    s_branch L_st_done
L_st_fl:
    global_load_dword v209, v183, s[18:19] offset:128 sc1
    s_mov_b32 s87, 1
    s_branch L_st_done
L_st_tag:
    v_readfirstlane_b32 s71, v208
    s_nop 0
    s_cmp_eq_u32 s71, 0
    s_cbranch_scc1 L_st_load
    s_lshl_b32 s3, s37, 5
    s_add_u32 s3, s3, s38
    s_lshl_b32 s3, s3, 7
    v_lshlrev_b32 v192, 4, v1
    v_add_u32 v192, s3, v192
    v_mov_b32 v196, s71
    v_mov_b32 v197, s71
    v_mov_b32 v198, s71
    v_mov_b32 v199, s71
    s_cmp_eq_u32 s3, 0
    s_movk_i32 s3, 0xff
    s_cselect_b32 s3, s3, 0
    s_or_b32 exec_lo, s3, 0xff00
    s_mov_b32 exec_hi, 0
    global_store_dwordx4 v192, v[196:199], s[18:19] sc1
    s_mov_b64 exec, -1
    s_cmp_lt_u32 s38, 24
    s_cselect_b32 s87, 0, 2
    s_branch L_st_done
L_st_clr:
L_st_load:
    v_mov_b32 v192, 0
    global_load_dword v208, v192, s[16:17] sc1
    s_mov_b32 s87, 3
L_st_done:
    s_add_u32 s69, s69, s55
    s_cbranch_scc1 L_lax9
    s_add_u32 s68, s68, s70
    s_cbranch_scc0 L_nrm9
    s_waitcnt vmcnt(5)
L_nrm9:
    s_waitcnt vmcnt(6)
L_lax9:
    s_waitcnt vmcnt(7)
    buffer_load_dwordx4 v[88:91], v3, s[24:27], s49 offen offset:0 nt
    s_nop 1
    v_cndmask_b32 v28, v28, v29, s[74:75]
    v_cndmask_b32 v30, v30, v31, s[74:75]
    v_cndmask_b32 v28, v28, v30, s[76:77]
    s_nop 1
    v_add_f32_dpp v29, v28, v28 row_ror:4 row_mask:0xf bank_mask:0xf
    s_nop 1
    v_add_f32_dpp v28, v29, v29 row_ror:8 row_mask:0xf bank_mask:0xf
    v_cndmask_b32 v28, v180, v28, s[56:57]
    s_add_u32 s69, s69, s55
    s_cbranch_scc1 L_lax10
    s_add_u32 s68, s68, s70
    s_cbranch_scc0 L_nrm10
    s_waitcnt vmcnt(5)
L_nrm10:
    s_waitcnt vmcnt(6)
L_lax10:
    s_waitcnt vmcnt(7)
    buffer_load_dwordx4 v[92:95], v3, s[24:27], s50 offen offset:0 nt
    v_mfma_f32_16x16x32_bf16 v[32:35], v[60:63], v[4:7], 0
    v_mfma_f32_16x16x32_bf16 v[32:35], v[64:67], v[8:11], v[32:35]
    s_add_u32 s69, s69, s55
    s_cbranch_scc1 L_lax11
    s_add_u32 s68, s68, s70
    s_cbranch_scc0 L_nrm11
    s_waitcnt vmcnt(5)
L_nrm11:
    s_waitcnt vmcnt(6)
L_lax11:
    s_waitcnt vmcnt(7)
    buffer_load_dwordx4 v[96:99], v3, s[24:27], s51 offen offset:0 nt
    s_nop 3
    v_cndmask_b32 v32, v32, v33, s[74:75]
    v_cndmask_b32 v34, v34, v35, s[74:75]
    v_cndmask_b32 v32, v32, v34, s[76:77]
    s_nop 1
    v_add_f32_dpp v33, v32, v32 row_ror:4 row_mask:0xf bank_mask:0xf
    s_nop 1
    v_add_f32_dpp v32, v33, v33 row_ror:8 row_mask:0xf bank_mask:0xf
    v_cndmask_b32 v32, v180, v32, s[58:59]
    s_add_u32 s69, s69, s55
    s_cbranch_scc1 L_lax12
    s_add_u32 s68, s68, s70
    s_cbranch_scc0 L_nrm12
    s_waitcnt vmcnt(5)
L_nrm12:
    s_waitcnt vmcnt(6)
L_lax12:
    s_waitcnt vmcnt(7)
    buffer_load_dwordx4 v[100:103], v3, s[24:27], s48 offen offset:256 nt
    v_mfma_f32_16x16x32_bf16 v[36:39], v[68:71], v[4:7], 0
    v_mfma_f32_16x16x32_bf16 v[36:39], v[72:75], v[8:11], v[36:39]
    s_add_u32 s69, s69, s55
    s_cbranch_scc1 L_lax13
    s_add_u32 s68, s68, s70
    s_cbranch_scc0 L_nrm13
    s_waitcnt vmcnt(4)
L_nrm13:
    s_waitcnt vmcnt(6)
L_lax13:
    s_waitcnt vmcnt(7)
    buffer_load_dwordx4 v[104:107], v3, s[24:27], s49 offen offset:256 nt
    s_nop 3
    v_cndmask_b32 v36, v36, v37, s[74:75]
    v_cndmask_b32 v38, v38, v39, s[74:75]
    v_cndmask_b32 v36, v36, v38, s[76:77]
    s_nop 1
    v_add_f32_dpp v37, v36, v36 row_ror:4 row_mask:0xf bank_mask:0xf
    s_nop 1
    v_add_f32_dpp v36, v37, v37 row_ror:8 row_mask:0xf bank_mask:0xf
    v_cndmask_b32 v36, v180, v36, s[60:61]
    s_add_u32 s69, s69, s55
    s_cbranch_scc1 L_lax14
    s_add_u32 s68, s68, s70
    s_cbranch_scc0 L_nrm14
    s_waitcnt vmcnt(4)
L_nrm14:
    s_waitcnt vmcnt(5)
L_lax14:
    s_waitcnt vmcnt(7)
    buffer_load_dwordx4 v[108:111], v3, s[24:27], s50 offen offset:256 nt
    global_load_dwordx2 v[214:215], v212, s[18:19] nt
    v_mfma_f32_16x16x32_bf16 v[40:43], v[76:79], v[4:7], 0
    v_mfma_f32_16x16x32_bf16 v[40:43], v[80:83], v[8:11], v[40:43]
    s_nop 7
    v_cndmask_b32 v40, v40, v41, s[74:75]
    v_cndmask_b32 v42, v42, v43, s[74:75]
    v_cndmask_b32 v40, v40, v42, s[76:77]
    s_nop 1
    v_add_f32_dpp v41, v40, v40 row_ror:4 row_mask:0xf bank_mask:0xf
    s_nop 1
    v_add_f32_dpp v40, v41, v41 row_ror:8 row_mask:0xf bank_mask:0xf
    v_cndmask_b32 v40, v180, v40, s[62:63]
    s_add_u32 s69, s69, s55
    s_cbranch_scc1 L_lax15
    s_add_u32 s68, s68, s70
    s_cbranch_scc0 L_nrm15
    s_waitcnt vmcnt(5)
L_nrm15:
    s_waitcnt vmcnt(6)
L_lax15:
    s_waitcnt vmcnt(7)
    buffer_load_dwordx4 v[112:115], v3, s[24:27], s51 offen offset:256 nt
    v_add_u32 v211, 1, v211
    s_mov_b64 exec, 1
    global_store_short v210, v211, s[18:19]
    s_mov_b64 exec, -1
    s_cmp_lg_u32 s72, 64
    s_cbranch_scc1 L_noswap0
    v_mov_b32 v12, v15
    v_mov_b32 v13, v16
    v_mov_b32 v14, v17
    s_mov_b32 s72, 0
L_noswap0:
    v_readlane_b32 s48, v12, s72
    s_add_u32 s3, s72, 1
    v_readlane_b32 s49, v12, s3
    s_add_u32 s3, s72, 2
    v_readlane_b32 s50, v12, s3
    s_add_u32 s3, s72, 3
    v_readlane_b32 s51, v12, s3
    v_max3_f32 v18, v18, v28, v32
    v_max3_f32 v18, v18, v36, v40
    v_mul_f32 v184, s80, v18
    v_sub_f32 v21, v19, v184
    v_fma_f32 v28, v28, s80, -v184
    v_fma_f32 v32, v32, s80, -v184
    v_fma_f32 v36, v36, s80, -v184
    v_fma_f32 v40, v40, s80, -v184
    v_exp_f32 v21, v21
    v_exp_f32 v28, v28
    v_exp_f32 v32, v32
    v_exp_f32 v36, v36
    v_exp_f32 v40, v40
    v_mov_b32 v19, v184
    v_mov_b32_dpp v22, v21 quad_perm:[0,0,0,0] row_mask:0xf bank_mask:0xf
    v_mov_b32_dpp v23, v21 quad_perm:[1,1,1,1] row_mask:0xf bank_mask:0xf
    v_mov_b32_dpp v24, v21 quad_perm:[2,2,2,2] row_mask:0xf bank_mask:0xf
    v_mov_b32_dpp v25, v21 quad_perm:[3,3,3,3] row_mask:0xf bank_mask:0xf
    v_add_f32 v184, v28, v32
    v_add_f32 v185, v36, v40
    v_cvt_pk_bf16_f32 v26, v28, v32
    v_cvt_pk_bf16_f32 v27, v36, v40
    v_add_f32 v184, v184, v185
    v_fma_f32 v20, v20, v21, v184
    s_sub_u32 s73, s73, 1
    s_cmp_gt_u32 s73, 1
    s_cbranch_scc1 L_loop
L_burst:
    buffer_load_dwordx4 v[52:55], v2, s[20:23], s48 offen offset:0 nt
    buffer_load_dwordx4 v[56:59], v2, s[20:23], s48 offen offset:256 nt
    buffer_load_dwordx4 v[60:63], v2, s[20:23], s49 offen offset:0 nt
    buffer_load_dwordx4 v[64:67], v2, s[20:23], s49 offen offset:256 nt
    buffer_load_dwordx4 v[68:71], v2, s[20:23], s50 offen offset:0 nt
    buffer_load_dwordx4 v[72:75], v2, s[20:23], s50 offen offset:256 nt
    buffer_load_dwordx4 v[76:79], v2, s[20:23], s51 offen offset:0 nt
    buffer_load_dwordx4 v[80:83], v2, s[20:23], s51 offen offset:256 nt
    v_add_u32 v211, 1, v211
    s_mov_b64 exec, 1
    global_store_short v210, v211, s[18:19]
    s_mov_b64 exec, -1
    v_readlane_b32 s56, v13, s72
    v_readlane_b32 s57, v14, s72
    s_add_u32 s72, s72, 1
    v_readlane_b32 s58, v13, s72
    v_readlane_b32 s59, v14, s72
    s_add_u32 s72, s72, 1
    v_readlane_b32 s60, v13, s72
    v_readlane_b32 s61, v14, s72
    s_add_u32 s72, s72, 1
    v_readlane_b32 s62, v13, s72
    v_readlane_b32 s63, v14, s72
    s_add_u32 s72, s72, 1
    v_pk_mul_f32 v[116:117], v[116:117], v[22:23]
    v_pk_mul_f32 v[118:119], v[118:119], v[24:25]
    v_pk_mul_f32 v[120:121], v[120:121], v[22:23]
    v_pk_mul_f32 v[122:123], v[122:123], v[24:25]
    v_pk_mul_f32 v[124:125], v[124:125], v[22:23]
    v_pk_mul_f32 v[126:127], v[126:127], v[24:25]
    v_pk_mul_f32 v[128:129], v[128:129], v[22:23]
    v_pk_mul_f32 v[130:131], v[130:131], v[24:25]
    v_pk_mul_f32 v[132:133], v[132:133], v[22:23]
    v_pk_mul_f32 v[134:135], v[134:135], v[24:25]
    v_pk_mul_f32 v[136:137], v[136:137], v[22:23]
    v_pk_mul_f32 v[138:139], v[138:139], v[24:25]
    v_pk_mul_f32 v[140:141], v[140:141], v[22:23]
    v_pk_mul_f32 v[142:143], v[142:143], v[24:25]
    v_pk_mul_f32 v[144:145], v[144:145], v[22:23]
    v_pk_mul_f32 v[146:147], v[146:147], v[24:25]
    v_pk_mul_f32 v[148:149], v[148:149], v[22:23]
    v_pk_mul_f32 v[150:151], v[150:151], v[24:25]
    v_pk_mul_f32 v[152:153], v[152:153], v[22:23]
    v_pk_mul_f32 v[154:155], v[154:155], v[24:25]
    v_pk_mul_f32 v[156:157], v[156:157], v[22:23]
    v_pk_mul_f32 v[158:159], v[158:159], v[24:25]
    v_pk_mul_f32 v[160:161], v[160:161], v[22:23]
    v_pk_mul_f32 v[162:163], v[162:163], v[24:25]
    v_pk_mul_f32 v[164:165], v[164:165], v[22:23]
    v_pk_mul_f32 v[166:167], v[166:167], v[24:25]
    v_pk_mul_f32 v[168:169], v[168:169], v[22:23]
    v_pk_mul_f32 v[170:171], v[170:171], v[24:25]
    v_pk_mul_f32 v[172:173], v[172:173], v[22:23]
    v_pk_mul_f32 v[174:175], v[174:175], v[24:25]
    v_pk_mul_f32 v[176:177], v[176:177], v[22:23]
    v_pk_mul_f32 v[178:179], v[178:179], v[24:25]
    s_waitcnt vmcnt(15)
    v_perm_b32 v44, v88, v84, s78
    v_perm_b32 v45, v96, v92, s78
    v_perm_b32 v46, v88, v84, s79
    v_perm_b32 v47, v96, v92, s79
    v_mfma_f32_4x4x4_16b_bf16 v[116:119], v[26:27], v[44:45], v[116:119]
    v_perm_b32 v48, v89, v85, s78
    v_perm_b32 v49, v97, v93, s78
    v_mfma_f32_4x4x4_16b_bf16 v[120:123], v[26:27], v[46:47], v[120:123]
    v_perm_b32 v50, v89, v85, s79
    v_perm_b32 v51, v97, v93, s79
    v_mfma_f32_4x4x4_16b_bf16 v[124:127], v[26:27], v[48:49], v[124:127]
    v_perm_b32 v44, v90, v86, s78
    v_perm_b32 v45, v98, v94, s78
    v_mfma_f32_4x4x4_16b_bf16 v[128:131], v[26:27], v[50:51], v[128:131]
    v_perm_b32 v46, v90, v86, s79
    v_perm_b32 v47, v98, v94, s79
    v_mfma_f32_4x4x4_16b_bf16 v[132:135], v[26:27], v[44:45], v[132:135]
    v_perm_b32 v48, v91, v87, s78
    v_perm_b32 v49, v99, v95, s78
    v_mfma_f32_4x4x4_16b_bf16 v[136:139], v[26:27], v[46:47], v[136:139]
    v_perm_b32 v50, v91, v87, s79
    v_perm_b32 v51, v99, v95, s79
    v_mfma_f32_4x4x4_16b_bf16 v[140:143], v[26:27], v[48:49], v[140:143]
    s_nop 0
    v_mfma_f32_4x4x4_16b_bf16 v[144:147], v[26:27], v[50:51], v[144:147]
    buffer_load_dwordx4 v[84:87], v3, s[24:27], s48 offen offset:0 nt
    buffer_load_dwordx4 v[88:91], v3, s[24:27], s49 offen offset:0 nt
    buffer_load_dwordx4 v[92:95], v3, s[24:27], s50 offen offset:0 nt
    buffer_load_dwordx4 v[96:99], v3, s[24:27], s51 offen offset:0 nt
    s_waitcnt vmcnt(14)
    v_perm_b32 v44, v104, v100, s78
    v_perm_b32 v45, v112, v108, s78
    v_perm_b32 v46, v104, v100, s79
    v_perm_b32 v47, v112, v108, s79
    v_mfma_f32_4x4x4_16b_bf16 v[148:151], v[26:27], v[44:45], v[148:151]
    v_perm_b32 v48, v105, v101, s78
    v_perm_b32 v49, v113, v109, s78
    v_mfma_f32_4x4x4_16b_bf16 v[152:155], v[26:27], v[46:47], v[152:155]
    v_perm_b32 v50, v105, v101, s79
    v_perm_b32 v51, v113, v109, s79
    v_mfma_f32_4x4x4_16b_bf16 v[156:159], v[26:27], v[48:49], v[156:159]
    v_perm_b32 v44, v106, v102, s78
    v_perm_b32 v45, v114, v110, s78
    v_mfma_f32_4x4x4_16b_bf16 v[160:163], v[26:27], v[50:51], v[160:163]
    v_perm_b32 v46, v106, v102, s79
    v_perm_b32 v47, v114, v110, s79
    v_mfma_f32_4x4x4_16b_bf16 v[164:167], v[26:27], v[44:45], v[164:167]
    v_perm_b32 v48, v107, v103, s78
    v_perm_b32 v49, v115, v111, s78
    v_mfma_f32_4x4x4_16b_bf16 v[168:171], v[26:27], v[46:47], v[168:171]
    v_perm_b32 v50, v107, v103, s79
    v_perm_b32 v51, v115, v111, s79
    v_mfma_f32_4x4x4_16b_bf16 v[172:175], v[26:27], v[48:49], v[172:175]
    s_nop 0
    v_mfma_f32_4x4x4_16b_bf16 v[176:179], v[26:27], v[50:51], v[176:179]
    buffer_load_dwordx4 v[100:103], v3, s[24:27], s48 offen offset:256 nt
    buffer_load_dwordx4 v[104:107], v3, s[24:27], s49 offen offset:256 nt
    buffer_load_dwordx4 v[108:111], v3, s[24:27], s50 offen offset:256 nt
    global_load_dwordx2 v[214:215], v212, s[18:19] nt
    buffer_load_dwordx4 v[112:115], v3, s[24:27], s51 offen offset:256 nt
    v_add_u32 v211, 1, v211
    s_mov_b64 exec, 1
    global_store_short v210, v211, s[18:19]
    s_mov_b64 exec, -1
L_burst_qk:
    s_waitcnt vmcnt(17)
    v_mfma_f32_16x16x32_bf16 v[28:31], v[52:55], v[4:7], 0
    v_mfma_f32_16x16x32_bf16 v[28:31], v[56:59], v[8:11], v[28:31]
    s_waitcnt vmcnt(15)
    v_mfma_f32_16x16x32_bf16 v[32:35], v[60:63], v[4:7], 0
    v_mfma_f32_16x16x32_bf16 v[32:35], v[64:67], v[8:11], v[32:35]
    s_nop 4
    v_cndmask_b32 v28, v28, v29, s[74:75]
    v_cndmask_b32 v30, v30, v31, s[74:75]
    v_cndmask_b32 v28, v28, v30, s[76:77]
    s_nop 1
    v_add_f32_dpp v29, v28, v28 row_ror:4 row_mask:0xf bank_mask:0xf
    s_nop 1
    v_add_f32_dpp v28, v29, v29 row_ror:8 row_mask:0xf bank_mask:0xf
    v_cndmask_b32 v28, v180, v28, s[56:57]
    s_waitcnt vmcnt(13)
    v_mfma_f32_16x16x32_bf16 v[36:39], v[68:71], v[4:7], 0
    v_mfma_f32_16x16x32_bf16 v[36:39], v[72:75], v[8:11], v[36:39]
    v_cndmask_b32 v32, v32, v33, s[74:75]
    v_cndmask_b32 v34, v34, v35, s[74:75]
    v_cndmask_b32 v32, v32, v34, s[76:77]
    s_nop 1
    v_add_f32_dpp v33, v32, v32 row_ror:4 row_mask:0xf bank_mask:0xf
    s_nop 1
    v_add_f32_dpp v32, v33, v33 row_ror:8 row_mask:0xf bank_mask:0xf
    v_cndmask_b32 v32, v180, v32, s[58:59]
    s_waitcnt vmcnt(11)
    v_mfma_f32_16x16x32_bf16 v[40:43], v[76:79], v[4:7], 0
    v_mfma_f32_16x16x32_bf16 v[40:43], v[80:83], v[8:11], v[40:43]
    v_cndmask_b32 v36, v36, v37, s[74:75]
    v_cndmask_b32 v38, v38, v39, s[74:75]
    v_cndmask_b32 v36, v36, v38, s[76:77]
    s_nop 1
    v_add_f32_dpp v37, v36, v36 row_ror:4 row_mask:0xf bank_mask:0xf
    s_nop 1
    v_add_f32_dpp v36, v37, v37 row_ror:8 row_mask:0xf bank_mask:0xf
    v_cndmask_b32 v36, v180, v36, s[60:61]
    v_cndmask_b32 v40, v40, v41, s[74:75]
    v_cndmask_b32 v42, v42, v43, s[74:75]
    v_cndmask_b32 v40, v40, v42, s[76:77]
    s_nop 1
    v_add_f32_dpp v41, v40, v40 row_ror:4 row_mask:0xf bank_mask:0xf
    s_nop 1
    v_add_f32_dpp v40, v41, v41 row_ror:8 row_mask:0xf bank_mask:0xf
    v_cndmask_b32 v40, v180, v40, s[62:63]
    v_max3_f32 v18, v18, v28, v32
    v_max3_f32 v18, v18, v36, v40
    v_mov_b32 v184, v18
    s_nop 1
    v_permlane32_swap_b32 v18, v184
    v_max_f32 v18, v18, v184
    v_mov_b32 v184, v18
    s_nop 1
    v_permlane16_swap_b32 v18, v184
    v_max_f32 v18, v18, v184
    v_mul_f32 v184, s80, v18
    v_sub_f32 v21, v19, v184
    v_fma_f32 v28, v28, s80, -v184
    v_fma_f32 v32, v32, s80, -v184
    v_fma_f32 v36, v36, s80, -v184
    v_fma_f32 v40, v40, s80, -v184
    v_exp_f32 v21, v21
    v_exp_f32 v28, v28
    v_exp_f32 v32, v32
    v_exp_f32 v36, v36
    v_exp_f32 v40, v40
    v_mov_b32 v19, v184
    v_mov_b32_dpp v22, v21 quad_perm:[0,0,0,0] row_mask:0xf bank_mask:0xf
    v_mov_b32_dpp v23, v21 quad_perm:[1,1,1,1] row_mask:0xf bank_mask:0xf
    v_mov_b32_dpp v24, v21 quad_perm:[2,2,2,2] row_mask:0xf bank_mask:0xf
    v_mov_b32_dpp v25, v21 quad_perm:[3,3,3,3] row_mask:0xf bank_mask:0xf
    v_add_f32 v184, v28, v32
    v_add_f32 v185, v36, v40
    v_cvt_pk_bf16_f32 v26, v28, v32
    v_cvt_pk_bf16_f32 v27, v36, v40
    v_add_f32 v184, v184, v185
    v_fma_f32 v20, v20, v21, v184
    s_sub_u32 s73, s73, 1
    s_cmp_eq_u32 s73, 0
    s_cbranch_scc1 L_drain
    s_cmp_lg_u32 s72, 64
    s_cbranch_scc1 L_noswap1
    v_mov_b32 v12, v15
    v_mov_b32 v13, v16
    v_mov_b32 v14, v17
    s_mov_b32 s72, 0
L_noswap1:
    v_readlane_b32 s48, v12, s72
    s_add_u32 s3, s72, 1
    v_readlane_b32 s49, v12, s3
    s_add_u32 s3, s72, 2
    v_readlane_b32 s50, v12, s3
    s_add_u32 s3, s72, 3
    v_readlane_b32 s51, v12, s3
    s_cmp_gt_u32 s73, 1
    s_nop 1
    s_cbranch_scc1 L_loop
    s_branch L_burst
L_drain:
    v_pk_mul_f32 v[116:117], v[116:117], v[22:23]
    v_pk_mul_f32 v[118:119], v[118:119], v[24:25]
    v_pk_mul_f32 v[120:121], v[120:121], v[22:23]
    v_pk_mul_f32 v[122:123], v[122:123], v[24:25]
    v_pk_mul_f32 v[124:125], v[124:125], v[22:23]
    v_pk_mul_f32 v[126:127], v[126:127], v[24:25]
    v_pk_mul_f32 v[128:129], v[128:129], v[22:23]
    v_pk_mul_f32 v[130:131], v[130:131], v[24:25]
    v_pk_mul_f32 v[132:133], v[132:133], v[22:23]
    v_pk_mul_f32 v[134:135], v[134:135], v[24:25]
    v_pk_mul_f32 v[136:137], v[136:137], v[22:23]
    v_pk_mul_f32 v[138:139], v[138:139], v[24:25]
    v_pk_mul_f32 v[140:141], v[140:141], v[22:23]
    v_pk_mul_f32 v[142:143], v[142:143], v[24:25]
    v_pk_mul_f32 v[144:145], v[144:145], v[22:23]
    v_pk_mul_f32 v[146:147], v[146:147], v[24:25]
    v_pk_mul_f32 v[148:149], v[148:149], v[22:23]
    v_pk_mul_f32 v[150:151], v[150:151], v[24:25]
    v_pk_mul_f32 v[152:153], v[152:153], v[22:23]
    v_pk_mul_f32 v[154:155], v[154:155], v[24:25]
    v_pk_mul_f32 v[156:157], v[156:157], v[22:23]
    v_pk_mul_f32 v[158:159], v[158:159], v[24:25]
    v_pk_mul_f32 v[160:161], v[160:161], v[22:23]
    v_pk_mul_f32 v[162:163], v[162:163], v[24:25]
    v_pk_mul_f32 v[164:165], v[164:165], v[22:23]
    v_pk_mul_f32 v[166:167], v[166:167], v[24:25]
    v_pk_mul_f32 v[168:169], v[168:169], v[22:23]
    v_pk_mul_f32 v[170:171], v[170:171], v[24:25]
    v_pk_mul_f32 v[172:173], v[172:173], v[22:23]
    v_pk_mul_f32 v[174:175], v[174:175], v[24:25]
    v_pk_mul_f32 v[176:177], v[176:177], v[22:23]
    v_pk_mul_f32 v[178:179], v[178:179], v[24:25]
    v_mov_b32 v185, v20
    v_lshrrev_b32 v186, 4, v1
    v_and_b32 v187, 15, v1
    v_permlane32_swap_b32 v20, v185
    v_lshlrev_b32 v186, 3, v186
    v_add_f32 v20, v20, v185
    v_lshl_add_u32 v186, v187, 5, v186
    v_mov_b32 v185, v20
    s_lshl_b32 s3, s36, 12
    v_add_u32 v186, s3, v186
    v_permlane16_swap_b32 v20, v185
    s_lshl_b32 s3, s36, 2
    v_add_f32 v20, v20, v185
    v_lshlrev_b32 v185, 4, v1
    v_add_u32 v187, s3, v185
    s_mov_b64 exec, 0xf
    ds_write_b32 v187, v19 offset:16448
    ds_write_b32 v187, v20 offset:16512
    s_mov_b64 exec, -1
    s_lshl_b32 s3, s36, 4
    v_mov_b32 v188, s3
    s_lshl_b32 s3, s36, 10
    v_add_u32 v189, s3, v185
    s_and_b32 s3, s38, 7
    s_lshl_b32 s3, s3, 2
    s_add_u32 s3, s3, s36
    s_lshr_b32 s44, s3, 3
    s_and_b32 s45, s3, 7
    s_lshl_b32 s39, s37, 2
    s_add_u32 s39, s39, s44
    v_lshrrev_b32 v190, 3, v1
    v_and_b32 v191, 7, v1
    v_lshlrev_b32 v200, 10, v190
    v_lshl_add_u32 v200, v191, 4, v200
    s_lshl_b32 s3, s39, 15
    s_lshl_b32 s46, s45, 7
    s_add_u32 s3, s3, s46
    s_add_u32 s3, s3, 262144
    v_add_u32 v200, s3, v200
    s_lshl_b32 s3, s39, 12
    s_add_u32 s3, s3, 65536
    v_lshlrev_b32 v204, 7, v190
    v_add_u32 v204, s3, v204
    v_and_b32 v206, 31, v1
    v_lshlrev_b32 v206, 7, v206
    v_add_u32 v206, s3, v206
    v_add_u32 v201, 8192, v200
    v_add_u32 v202, 16384, v200
    v_add_u32 v203, 24576, v200
    s_lshr_b32 s3, s44, 1
    s_lshl_b32 s3, s3, 13
    s_lshl_b32 s46, s37, 10
    s_add_u32 s3, s3, s46
    s_and_b32 s46, s44, 1
    s_lshl_b32 s46, s46, 9
    s_add_u32 s3, s3, s46
    s_lshl_b32 s46, s45, 6
    s_add_u32 s3, s3, s46
    v_lshrrev_b32 v205, 4, v1
    v_lshlrev_b32 v205, 1, v205
    v_lshl_add_u32 v205, v191, 3, v205
    v_add_u32 v205, s3, v205
    s_mov_b32 s42, 0
    s_mov_b64 s[56:57], -1
    s_mov_b64 s[58:59], -1
    s_mov_b64 s[60:61], -1
    s_mov_b64 s[62:63], -1
    s_waitcnt vmcnt(6)
    v_perm_b32 v44, v88, v84, s78
    v_perm_b32 v45, v96, v92, s78
    v_perm_b32 v46, v88, v84, s79
    v_perm_b32 v47, v96, v92, s79
    v_mfma_f32_4x4x4_16b_bf16 v[116:119], v[26:27], v[44:45], v[116:119]
    v_perm_b32 v48, v89, v85, s78
    v_perm_b32 v49, v97, v93, s78
    v_mfma_f32_4x4x4_16b_bf16 v[120:123], v[26:27], v[46:47], v[120:123]
    v_perm_b32 v50, v89, v85, s79
    v_perm_b32 v51, v97, v93, s79
    v_mfma_f32_4x4x4_16b_bf16 v[124:127], v[26:27], v[48:49], v[124:127]
    v_perm_b32 v44, v90, v86, s78
    v_perm_b32 v45, v98, v94, s78
    v_mfma_f32_4x4x4_16b_bf16 v[128:131], v[26:27], v[50:51], v[128:131]
    v_perm_b32 v46, v90, v86, s79
    v_perm_b32 v47, v98, v94, s79
    v_mfma_f32_4x4x4_16b_bf16 v[132:135], v[26:27], v[44:45], v[132:135]
    v_perm_b32 v48, v91, v87, s78
    v_perm_b32 v49, v99, v95, s78
    v_mfma_f32_4x4x4_16b_bf16 v[136:139], v[26:27], v[46:47], v[136:139]
    v_perm_b32 v50, v91, v87, s79
    v_perm_b32 v51, v99, v95, s79
    v_mfma_f32_4x4x4_16b_bf16 v[140:143], v[26:27], v[48:49], v[140:143]
    s_nop 0
    v_mfma_f32_4x4x4_16b_bf16 v[144:147], v[26:27], v[50:51], v[144:147]
    v_permlane32_swap_b32 v116, v132
    v_permlane32_swap_b32 v117, v133
    v_permlane32_swap_b32 v118, v134
    v_permlane32_swap_b32 v119, v135
    v_permlane32_swap_b32 v120, v136
    v_permlane32_swap_b32 v121, v137
    v_permlane32_swap_b32 v122, v138
    v_permlane32_swap_b32 v123, v139
    v_permlane32_swap_b32 v124, v140
    v_permlane32_swap_b32 v125, v141
    v_permlane32_swap_b32 v126, v142
    v_permlane32_swap_b32 v127, v143
    v_permlane32_swap_b32 v128, v144
    v_permlane32_swap_b32 v129, v145
    v_permlane32_swap_b32 v130, v146
    v_permlane32_swap_b32 v131, v147
    v_pk_add_f32 v[116:117], v[116:117], v[132:133]
    v_pk_add_f32 v[118:119], v[118:119], v[134:135]
    v_pk_add_f32 v[120:121], v[120:121], v[136:137]
    v_pk_add_f32 v[122:123], v[122:123], v[138:139]
    v_pk_add_f32 v[124:125], v[124:125], v[140:141]
    v_pk_add_f32 v[126:127], v[126:127], v[142:143]
    v_pk_add_f32 v[128:129], v[128:129], v[144:145]
    v_pk_add_f32 v[130:131], v[130:131], v[146:147]
    v_permlane16_swap_b32 v116, v124
    v_permlane16_swap_b32 v117, v125
    v_permlane16_swap_b32 v118, v126
    v_permlane16_swap_b32 v119, v127
    v_permlane16_swap_b32 v120, v128
    v_permlane16_swap_b32 v121, v129
    v_permlane16_swap_b32 v122, v130
    v_permlane16_swap_b32 v123, v131
    v_add_f32 v52, v116, v124
    v_add_f32 v53, v120, v128
    ds_write_b64 v186, v[52:53] offset:20480
    v_add_f32 v54, v117, v125
    v_add_f32 v55, v121, v129
    ds_write_b64 v186, v[54:55] offset:21504
    v_add_f32 v56, v118, v126
    v_add_f32 v57, v122, v130
    ds_write_b64 v186, v[56:57] offset:22528
    v_add_f32 v58, v119, v127
    v_add_f32 v59, v123, v131
    ds_write_b64 v186, v[58:59] offset:23552
    s_waitcnt vmcnt(0)
    v_perm_b32 v44, v104, v100, s78
    v_perm_b32 v45, v112, v108, s78
    v_perm_b32 v46, v104, v100, s79
    v_perm_b32 v47, v112, v108, s79
    v_mfma_f32_4x4x4_16b_bf16 v[148:151], v[26:27], v[44:45], v[148:151]
    v_perm_b32 v48, v105, v101, s78
    v_perm_b32 v49, v113, v109, s78
    v_mfma_f32_4x4x4_16b_bf16 v[152:155], v[26:27], v[46:47], v[152:155]
    v_perm_b32 v50, v105, v101, s79
    v_perm_b32 v51, v113, v109, s79
    v_mfma_f32_4x4x4_16b_bf16 v[156:159], v[26:27], v[48:49], v[156:159]
    v_perm_b32 v44, v106, v102, s78
    v_perm_b32 v45, v114, v110, s78
    v_mfma_f32_4x4x4_16b_bf16 v[160:163], v[26:27], v[50:51], v[160:163]
    v_perm_b32 v46, v106, v102, s79
    v_perm_b32 v47, v114, v110, s79
    v_mfma_f32_4x4x4_16b_bf16 v[164:167], v[26:27], v[44:45], v[164:167]
    v_perm_b32 v48, v107, v103, s78
    v_perm_b32 v49, v115, v111, s78
    v_mfma_f32_4x4x4_16b_bf16 v[168:171], v[26:27], v[46:47], v[168:171]
    v_perm_b32 v50, v107, v103, s79
    v_perm_b32 v51, v115, v111, s79
    v_mfma_f32_4x4x4_16b_bf16 v[172:175], v[26:27], v[48:49], v[172:175]
    s_nop 0
    v_mfma_f32_4x4x4_16b_bf16 v[176:179], v[26:27], v[50:51], v[176:179]
    v_permlane32_swap_b32 v148, v164
    v_permlane32_swap_b32 v149, v165
    v_permlane32_swap_b32 v150, v166
    v_permlane32_swap_b32 v151, v167
    v_permlane32_swap_b32 v152, v168
    v_permlane32_swap_b32 v153, v169
    v_permlane32_swap_b32 v154, v170
    v_permlane32_swap_b32 v155, v171
    v_permlane32_swap_b32 v156, v172
    v_permlane32_swap_b32 v157, v173
    v_permlane32_swap_b32 v158, v174
    v_permlane32_swap_b32 v159, v175
    v_permlane32_swap_b32 v160, v176
    v_permlane32_swap_b32 v161, v177
    v_permlane32_swap_b32 v162, v178
    v_permlane32_swap_b32 v163, v179
    v_pk_add_f32 v[148:149], v[148:149], v[164:165]
    v_pk_add_f32 v[150:151], v[150:151], v[166:167]
    v_pk_add_f32 v[152:153], v[152:153], v[168:169]
    v_pk_add_f32 v[154:155], v[154:155], v[170:171]
    v_pk_add_f32 v[156:157], v[156:157], v[172:173]
    v_pk_add_f32 v[158:159], v[158:159], v[174:175]
    v_pk_add_f32 v[160:161], v[160:161], v[176:177]
    v_pk_add_f32 v[162:163], v[162:163], v[178:179]
    v_permlane16_swap_b32 v148, v156
    v_permlane16_swap_b32 v149, v157
    v_permlane16_swap_b32 v150, v158
    v_permlane16_swap_b32 v151, v159
    v_permlane16_swap_b32 v152, v160
    v_permlane16_swap_b32 v153, v161
    v_permlane16_swap_b32 v154, v162
    v_permlane16_swap_b32 v155, v163
    v_add_f32 v60, v148, v156
    v_add_f32 v61, v152, v160
    ds_write_b64 v186, v[60:61] offset:20992
    v_add_f32 v62, v149, v157
    v_add_f32 v63, v153, v161
    ds_write_b64 v186, v[62:63] offset:22016
    v_add_f32 v64, v150, v158
    v_add_f32 v65, v154, v162
    ds_write_b64 v186, v[64:65] offset:23040
    v_add_f32 v66, v151, v159
    v_add_f32 v67, v155, v163
    ds_write_b64 v186, v[66:67] offset:24064
    s_cmp_eq_u32 s87, 0
    s_cbranch_scc1 L_chk_ok
    s_cmp_lt_u32 s87, 3
    s_cbranch_scc1 L_chk
    s_mov_b32 s52, s54
    s_mov_b32 s53, 0
    s_waitcnt lgkmcnt(0)
    s_atomic_cmpswap s[52:53], s[16:17], 0x0 glc
    s_waitcnt lgkmcnt(0)
    s_cmp_eq_u32 s52, 0
    s_cselect_b32 s71, s54, s52
    s_lshl_b32 s3, s37, 5
    s_add_u32 s3, s3, s38
    s_lshl_b32 s3, s3, 7
    v_lshlrev_b32 v192, 4, v1
    v_add_u32 v192, s3, v192
    v_mov_b32 v196, s71
    v_mov_b32 v197, s71
    v_mov_b32 v198, s71
    v_mov_b32 v199, s71
    s_cmp_eq_u32 s3, 0
    s_movk_i32 s3, 0xff
    s_cselect_b32 s3, s3, 0
    s_or_b32 exec_lo, s3, 0xff00
    s_mov_b32 exec_hi, 0
    global_store_dwordx4 v192, v[196:199], s[18:19] sc1
    s_mov_b64 exec, -1
    s_cmp_lt_u32 s38, 24
    s_cbranch_scc1 L_chk_ok
L_chk:
    global_load_dword v209, v183, s[18:19] offset:128 sc1
    s_waitcnt vmcnt(0)
    v_cmp_ne_u32 vcc, s71, v209
    s_cbranch_vccnz L_chk
L_chk_ok:
    s_waitcnt lgkmcnt(0)
    s_barrier
    ds_read_b128 v[28:31], v188 offset:16448
    ds_read_b128 v[32:35], v188 offset:16512
    ds_read_b128 v[84:87], v189 offset:20480
    ds_read_b128 v[88:91], v189 offset:24576
    ds_read_b128 v[92:95], v189 offset:28672
    ds_read_b128 v[96:99], v189 offset:32768
    s_waitcnt lgkmcnt(4)
    v_max_f32 v18, v28, v29
    v_max3_f32 v18, v18, v30, v31
    v_sub_f32 v28, v28, v18
    v_sub_f32 v29, v29, v18
    v_sub_f32 v30, v30, v18
    v_sub_f32 v31, v31, v18
    v_exp_f32 v28, v28
    v_exp_f32 v29, v29
    v_exp_f32 v30, v30
    v_exp_f32 v31, v31
    s_waitcnt lgkmcnt(3)
    v_pk_mul_f32 v[52:53], v[84:85], v[28:29] op_sel_hi:[1,0]
    v_pk_mul_f32 v[54:55], v[86:87], v[28:29] op_sel_hi:[1,0]
    s_waitcnt lgkmcnt(2)
    v_fmac_f32 v52, v29, v88
    v_fmac_f32 v53, v29, v89
    v_fmac_f32 v54, v29, v90
    v_fmac_f32 v55, v29, v91
    s_waitcnt lgkmcnt(1)
    v_fmac_f32 v52, v30, v92
    v_fmac_f32 v53, v30, v93
    v_fmac_f32 v54, v30, v94
    v_fmac_f32 v55, v30, v95
    s_waitcnt lgkmcnt(0)
    v_fmac_f32 v52, v31, v96
    v_fmac_f32 v53, v31, v97
    v_fmac_f32 v54, v31, v98
    v_fmac_f32 v55, v31, v99
    v_min_u32 v52, -2, v52
    v_min_u32 v53, -2, v53
    v_min_u32 v54, -2, v54
    v_min_u32 v55, -2, v55
    global_store_dwordx4 v181, v[52:55], s[18:19] sc1
    v_mul_f32 v19, v28, v32
    v_fmac_f32 v19, v29, v33
    v_fmac_f32 v19, v30, v34
    v_fmac_f32 v19, v31, v35
    v_min_u32 v18, -2, v18
    v_min_u32 v19, -2, v19
    v_mov_b32 v20, v18
    v_mov_b32 v21, v19
    s_mov_b64 exec, 0xff
    global_store_dwordx4 v182, v[18:21], s[18:19] sc1
    s_cmp_lt_u32 s38, 24
    s_cbranch_scc1 L_fin
    s_mov_b32 exec_lo, -1
    s_mov_b32 exec_hi, 0
L_pml:
    global_load_dword v100, v206, s[18:19] sc1
    s_waitcnt vmcnt(0)
L_pml1:
    v_cmp_eq_u32 vcc, -1, v100
    s_nop 0
    s_and_b64 exec, exec, vcc
    s_bcnt1_i32_b64 s3, exec
    s_cmp_gt_u32 s3, 8
    s_cbranch_scc1 L_pml
L_poll:
    s_mov_b64 exec, s[56:57]
    s_cbranch_execz L_skip0
    global_load_dwordx4 v[84:87], v200, s[18:19] sc1
    global_load_dwordx2 v[100:101], v204, s[18:19] offset:0 sc1
L_skip0:
    s_mov_b64 exec, s[58:59]
    s_cbranch_execz L_skip1
    global_load_dwordx4 v[88:91], v201, s[18:19] sc1
    global_load_dwordx2 v[102:103], v204, s[18:19] offset:1024 sc1
L_skip1:
    s_mov_b64 exec, s[60:61]
    s_cbranch_execz L_skip2
    global_load_dwordx4 v[92:95], v202, s[18:19] sc1
    global_load_dwordx2 v[104:105], v204, s[18:19] offset:2048 sc1
L_skip2:
    s_mov_b64 exec, s[62:63]
    s_cbranch_execz L_skip3
    global_load_dwordx4 v[96:99], v203, s[18:19] sc1
    global_load_dwordx2 v[106:107], v204, s[18:19] offset:3072 sc1
L_skip3:
    s_mov_b64 exec, -1
    s_waitcnt vmcnt(0)
    v_max3_u32 v46, v84, v85, v86
    v_max3_u32 v47, v87, v100, v101
    v_max_u32 v46, v46, v47
    v_cmp_eq_u32 s[56:57], -1, v46
    v_max3_u32 v46, v88, v89, v90
    v_max3_u32 v47, v91, v102, v103
    v_max_u32 v46, v46, v47
    v_cmp_eq_u32 s[58:59], -1, v46
    v_max3_u32 v46, v92, v93, v94
    v_max3_u32 v47, v95, v104, v105
    v_max_u32 v46, v46, v47
    v_cmp_eq_u32 s[60:61], -1, v46
    v_max3_u32 v46, v96, v97, v98
    v_max3_u32 v47, v99, v106, v107
    v_max_u32 v46, v46, v47
    v_cmp_eq_u32 s[62:63], -1, v46
    s_or_b64 s[64:65], s[56:57], s[58:59]
    s_or_b64 s[66:67], s[60:61], s[62:63]
    s_or_b64 s[64:65], s[64:65], s[66:67]
    s_cbranch_scc1 L_poll
    v_max_f32 v44, v100, v102
    v_max3_f32 v44, v44, v104, v106
    s_nop 1
    v_max_f32_dpp v44, v44, v44 row_ror:8 row_mask:0xf bank_mask:0xf
    v_mov_b32 v45, v44
    s_nop 1
    v_permlane16_swap_b32 v44, v45
    v_max_f32 v44, v44, v45
    v_mov_b32 v45, v44
    s_nop 1
    v_permlane32_swap_b32 v44, v45
    v_max_f32 v44, v44, v45
    v_sub_f32 v28, v100, v44
    v_sub_f32 v29, v102, v44
    v_sub_f32 v30, v104, v44
    v_sub_f32 v31, v106, v44
    v_exp_f32 v28, v28
    v_exp_f32 v29, v29
    v_exp_f32 v30, v30
    v_exp_f32 v31, v31
    v_mul_f32 v44, v28, v101
    v_pk_mul_f32 v[32:33], v[84:85], v[28:29] op_sel_hi:[1,0]
    v_pk_mul_f32 v[34:35], v[86:87], v[28:29] op_sel_hi:[1,0]
    v_fmac_f32 v44, v29, v103
    v_fmac_f32 v32, v29, v88
    v_fmac_f32 v33, v29, v89
    v_fmac_f32 v34, v29, v90
    v_fmac_f32 v35, v29, v91
    v_fmac_f32 v44, v30, v105
    v_fmac_f32 v32, v30, v92
    v_fmac_f32 v33, v30, v93
    v_fmac_f32 v34, v30, v94
    v_fmac_f32 v35, v30, v95
    v_fmac_f32 v44, v31, v107
    v_fmac_f32 v32, v31, v96
    v_fmac_f32 v33, v31, v97
    v_fmac_f32 v34, v31, v98
    v_fmac_f32 v35, v31, v99
    v_mov_b32 v45, v44
    v_permlane32_swap_b32 v32, v34
    v_permlane32_swap_b32 v33, v35
    v_permlane32_swap_b32 v44, v45
    v_add_f32 v32, v32, v34
    v_add_f32 v33, v33, v35
    v_add_f32 v44, v44, v45
    v_mov_b32 v45, v44
    v_permlane16_swap_b32 v32, v33
    s_nop 0
    v_permlane16_swap_b32 v44, v45
    v_add_f32 v32, v32, v33
    v_add_f32 v44, v44, v45
    s_nop 0
    v_add_f32_dpp v32, v32, v32 row_ror:8 row_mask:0xf bank_mask:0xf
    v_add_f32_dpp v44, v44, v44 row_ror:8 row_mask:0xf bank_mask:0xf
    v_rcp_f32 v44, v44
    s_mov_b32 exec_lo, 0x00ff00ff
    s_mov_b32 exec_hi, 0x00ff00ff
    v_mul_f32 v32, v32, v44
    v_cvt_pk_bf16_f32 v32, v32, v32
    global_store_short v205, v32, s[14:15]
L_fin:
L_end:
    s_endpgm
.section .rodata,"a"
.p2align 6
.amdhsa_kernel standalone__paged_block_table_kv_radixattention__decode_kernel
  .amdhsa_next_free_vgpr 216
  .amdhsa_next_free_sgpr 102
  .amdhsa_accum_offset 216
  .amdhsa_group_segment_fixed_size 0
  .amdhsa_kernarg_size 64
  .amdhsa_user_sgpr_count 2
  .amdhsa_user_sgpr_kernarg_segment_ptr 1
  .amdhsa_system_sgpr_workgroup_id_x 1
  .amdhsa_float_denorm_mode_32 3
.end_amdhsa_kernel
```
